```python
import torch

def _softmax(x, axis=-1):
    return torch.softmax(x, dim=axis)
def _gelu(x):
    return torch.nn.functional.gelu(x, approximate="tanh")
def _silu(x):
    return torch.nn.functional.silu(x)
def _sigmoid(x):
    return torch.sigmoid(x)
def _layernorm(x, axis=-1, eps=1e-5):
    m = x.mean(dim=axis, keepdim=True)
    v = x.var(dim=axis, keepdim=True, unbiased=False)
    return (x - m) / torch.sqrt(v + eps)
def _scatter_add(tgt, idx, src, axis=0):
    return tgt.clone().index_add_(axis, idx, src)
def _segment_sum(src, seg, n):
    out = torch.zeros((n,) + src.shape[1:], dtype=src.dtype)
    return out.index_add_(0, seg, src)
def _pad(x, pw):
    flat = tuple(v for pair in reversed(pw) for v in pair)
    return torch.nn.functional.pad(x, flat)

kernel_name = 'sequential_preLN__sliding_block_cached__dense_activation_silu__decode'

def setup_inputs():

    _w = (lambda a: (lambda t: t.to(torch.bfloat16) if t.is_floating_point() else t)(torch.as_tensor(a)))
    def _A_setup():
        B, Sq, D = 1, 1, 512
        Hq, Hkv, Sk, Dh = 32, 8, 32768, 128
        assert Hq % Hkv == 0, (Hq, Hkv)
        return {
            "x": _w((lambda *s: torch.randn(*s, dtype=torch.bfloat16) * 0.05)(B, Sq, D)),
            "k_cache": _w((lambda *s: torch.randn(*s, dtype=torch.bfloat16) * 3.2)(B, Hkv, Sk, Dh)),
            "v_cache": _w((lambda *s: torch.randn(*s, dtype=torch.bfloat16) * 0.8)(B, Hkv, Sk, Dh)),
            "wq": _w((lambda *s: torch.randn(*s, dtype=torch.bfloat16) * 3.2)(D, Hq * Dh) * (D ** -0.5)),
            "wo": _w((lambda *s: torch.randn(*s, dtype=torch.bfloat16) * 0.8)(Hq * Dh, D) * ((Hq * Dh) ** -0.5)),
        }
    _A_in = _A_setup()

    def _B_setup():
        B, S, D, F = 1, 1, 512, 1792
        return {
            "x": _w((lambda *s: torch.randn(*s, dtype=torch.bfloat16) * 0.05)(B, S, D)),
            "w1": _w((lambda *s: torch.randn(*s, dtype=torch.bfloat16) * 3.2)(D, F) * (D ** -0.5)),
            "w2": _w((lambda *s: torch.randn(*s, dtype=torch.bfloat16) * 0.4)(F, D) * (F ** -0.5)),
        }
    _B_in = _B_setup()

    return {
        "A_x": _A_in["x"],
        "A_k_cache": _A_in["k_cache"],
        "A_v_cache": _A_in["v_cache"],
        "A_wq": _A_in["wq"],
        "A_wo": _A_in["wo"],
        "B_x": _B_in["x"],
        "B_w1": _B_in["w1"],
        "B_w2": _B_in["w2"],
    }

def reference(A_x, A_k_cache, A_v_cache, A_wq, A_wo, B_x, B_w1, B_w2):
    def _A_ref(x, k_cache, v_cache, wq, wo):
        B, Sq, D = x.shape
        Hq, Dh = 32, 128
        Hkv, Sk = k_cache.shape[1], k_cache.shape[2]
        W = min(4096, max(256, Sk // 4))
        rep = Hq // Hkv
        q = (lambda x, *d: x.permute(*d))((x @ wq).reshape(B, Sq, Hq, Dh), 0, 2, 1, 3)
        k = (lambda x, n, axis: torch.repeat_interleave(x, n, dim=axis))(k_cache[:, :, Sk - W:, :], rep, axis=1)
        v = (lambda x, n, axis: torch.repeat_interleave(x, n, dim=axis))(v_cache[:, :, Sk - W:, :], rep, axis=1)
        scores = torch.einsum("bhqd,bhkd->bhqk", q, k) * (Dh ** -0.5)
        p = _softmax(scores, axis=-1)
        o = torch.einsum("bhqk,bhkd->bhqd", p, v)
        return (lambda x, *d: x.permute(*d))(o, 0, 2, 1, 3).reshape(B, Sq, Hq * Dh) @ wo

    def _B_ref(x, w1, w2):
        h = torch.einsum("bsd,df->bsf", x, w1)
        h = _silu(h)
        out = torch.einsum("bsf,fd->bsd", h, w2)
        return out

    x = A_x
    h = x + _A_ref(_layernorm(x, axis=-1), A_k_cache, A_v_cache, A_wq, A_wo)
    h2 = h + _B_ref(_layernorm(h, axis=-1), B_w1, B_w2)
    return h2
```

```asm
; @launch grid=(256,1,1) block=(640,1,1) lds=107520
.amdgcn_target "amdgcn-amd-amdhsa--gfx950"
.text
.globl sequential_preLN__sliding_block_cached__dense_activation_silu__decode_kernel
.p2align 8
.type sequential_preLN__sliding_block_cached__dense_activation_silu__decode_kernel,@function
sequential_preLN__sliding_block_cached__dense_activation_silu__decode_kernel:

    s_cmp_ge_u32 s2, 256
    s_cbranch_scc1 L_exit
    s_load_dwordx2 s[16:17], s[0:1], 24
    s_load_dwordx2 s[32:33], s[0:1], 0
    s_load_dwordx2 s[8:9], s[0:1], 8
    s_load_dwordx2 s[28:29], s[0:1], 80
    s_load_dwordx2 s[12:13], s[0:1], 16
    v_lshrrev_b32 v1, 6, v0
    v_and_b32 v0, 63, v0
    s_and_b32 s4, s2, 7
    s_lshr_b32 s5, s2, 3
    v_readfirstlane_b32 s62, v1
    s_mov_b32 s18, 4194304
    s_mov_b32 s19, 0x20000
    s_mov_b32 s10, 67108864
    s_mov_b32 s11, 0x20000
    s_mov_b32 s30, 0x10000000
    s_mov_b32 s31, 0x20000

    s_cmp_eq_u32 s62, 0
    s_cbranch_scc1 L_comm
    s_cmp_eq_u32 s62, 9
    s_cbranch_scc1 L_help

    s_sub_u32 s3, s62, 1
    v_lshrrev_b32 v1, 3, v0
    v_and_b32 v2, 7, v0
    v_and_b32 v3, 6, v1
    v_xor_b32 v2, v2, v3
    v_lshlrev_b32 v2, 4, v2
    v_lshl_or_b32 v13, v1, 13, v2
    s_lshr_b32 s6, s5, 3
    s_lshl_b32 s37, s6, 20
    s_lshl_b32 s7, s3, 17
    s_add_u32 s37, s37, s7
    s_lshl_b32 s7, s4, 10
    s_add_u32 s37, s37, s7
    s_and_b32 s7, s5, 7
    s_lshl_b32 s7, s7, 7
    s_add_u32 s37, s37, s7
    s_add_u32 s38, s37, 64512
    s_lshl_b32 s39, s3, 12
    s_mov_b32 m0, s39
    v_and_b32 v3, 15, v0
    v_lshrrev_b32 v4, 4, v0
    v_xor_b32 v5, v3, v4
    v_lshlrev_b32 v5, 4, v5
    v_lshl_or_b32 v5, v4, 8, v5
    s_lshl_b32 s36, s4, 23
    s_lshl_b32 s7, s5, 15
    s_add_u32 s36, s36, s7
    s_add_u32 s36, s36, s39
    s_add_u32 s36, s36, 7340032
    s_add_u32 s40, s39, 32768
    s_mov_b32 s14, 67108864
    s_mov_b32 s15, 0x20000
    s_waitcnt lgkmcnt(0)
    buffer_load_dwordx4 v13, s[16:19], s37 offen nt lds
    buffer_load_dwordx4 v13, s[16:19], s38 offen offset:1024 nt lds
    s_mov_b32 m0, s40
    v_xor_b32 v8, 64, v5

    s_barrier
    buffer_load_dwordx4 v5, s[8:11], s36 offen nt lds

    s_load_dwordx2 s[34:35], s[0:1], 64
    s_load_dword s43, s[28:29], 0x0
    s_load_dwordx2 s[24:25], s[0:1], 56
    s_load_dwordx2 s[20:21], s[0:1], 32
    s_load_dwordx2 s[60:61], s[0:1], 48
    v_xor_b32 v9, 128, v5
    v_xor_b32 v10, 192, v5
    v_lshlrev_b32 v6, 1, v4
    v_xor_b32 v6, v6, v3
    v_lshlrev_b32 v6, 4, v6
    v_lshl_or_b32 v6, v4, 8, v6
    v_xor_b32 v7, 128, v6
    s_mov_b32 s48, 0x000f000f
    s_mov_b32 s49, 0x000f000f
    s_mov_b32 s23, 0x20000
    s_mov_b32 s26, 1835008
    s_mov_b32 s27, 0x20000
    s_lshl_b32 s7, s6, 8
    s_lshl_b32 s44, s3, 5
    s_add_u32 s7, s7, s44
    s_add_u32 s7, s7, 98304
    v_lshlrev_b32 v11, 3, v4
    v_add_u32 v11, s7, v11
    v_lshrrev_b32 v12, 2, v0
    v_and_b32 v13, 6, v12
    v_bfe_u32 v14, v0, 1, 1
    v_and_b32 v15, 1, v0
    v_lshlrev_b32 v15, 3, v15
    v_lshl_or_b32 v15, v12, 7, v15
    v_add_u32 v15, s39, v15

    v_add_u32 v16, 0, v14
    v_xor_b32 v16, v16, v13
    v_lshl_add_u32 v20, v16, 4, v15
    v_add_u32 v16, 2, v14
    v_xor_b32 v16, v16, v13
    v_lshl_add_u32 v21, v16, 4, v15
    v_add_u32 v16, 4, v14
    v_xor_b32 v16, v16, v13
    v_lshl_add_u32 v22, v16, 4, v15
    v_add_u32 v16, 6, v14
    v_xor_b32 v16, v16, v13
    v_lshl_add_u32 v23, v16, 4, v15

    v_cmp_eq_u32 s[54:55], 1, v4
    v_cmp_eq_u32 s[56:57], 2, v4
    v_cmp_eq_u32 s[58:59], 3, v4
    v_lshlrev_b32 v13, 2, v0
    s_lshl_b32 s7, s3, 8
    s_add_u32 s7, s7, 99328
    v_add_u32 v13, s7, v13
    s_waitcnt lgkmcnt(0)
    s_mov_b32 s22, 4194304
    s_cmp_lt_u32 s5, 16
    s_cselect_b32 s20, s20, s60
    s_cselect_b32 s21, s21, s61
    s_cselect_b32 s22, s22, s26
    s_waitcnt vmcnt(1)

    buffer_load_dwordx4 v8, s[8:11], s36 offen offset:1024 nt lds

    ds_read_b64_tr_b16 v[24:25], v20
    ds_read_b64_tr_b16 v[26:27], v21
    ds_read_b64_tr_b16 v[28:29], v22
    ds_read_b64_tr_b16 v[30:31], v23
    s_barrier
    ds_read_b64 v[32:33], v11
    s_waitcnt lgkmcnt(0)
    v_mfma_f32_16x16x16_bf16 v[36:39], v[32:33], v[24:25], 0
    v_mfma_f32_16x16x16_bf16 v[40:43], v[32:33], v[26:27], 0
    v_mfma_f32_16x16x16_bf16 v[44:47], v[32:33], v[28:29], 0
    v_mfma_f32_16x16x16_bf16 v[48:51], v[32:33], v[30:31], 0
    s_nop 6
    v_cndmask_b32 v36, v36, v40, s[54:55]
    v_cndmask_b32 v36, v36, v44, s[56:57]
    s_nop 0
    v_cndmask_b32 v36, v36, v48, s[58:59]
    ds_write_b32 v13, v36

    s_waitcnt lgkmcnt(0)
    s_barrier
    s_waitcnt vmcnt(1)
    buffer_load_dwordx4 v9, s[8:11], s36 offen offset:2048 nt lds
    s_waitcnt vmcnt(1)
    buffer_load_dwordx4 v10, s[8:11], s36 offen offset:3072 nt lds

    s_add_u32 s7, s39, 65536
    s_mov_b32 m0, s7
    v_xor_b32 v12, v4, v3
    v_lshlrev_b32 v12, 4, v12
    v_lshl_or_b32 v12, v3, 8, v12
    v_add_u32 v12, s40, v12
    v_xor_b32 v13, 64, v12
    v_xor_b32 v14, 128, v12
    v_xor_b32 v15, 192, v12
    s_waitcnt vmcnt(1)
    buffer_load_dwordx4 v6, s[12:15], s36 offen nt lds
    v_and_b32 v8, 3, v0
    v_mul_u32_u24 v60, 320, v8
    v_lshl_add_u32 v60, v4, 4, v60
    v_add_u32 v9, 101376, v60
    v_add_u32 v69, 102912, v60
    v_lshrrev_b32 v61, 2, v3
    v_mul_u32_u24 v61, 320, v61
    v_lshl_add_u32 v61, v4, 4, v61
    v_add_u32 v61, 102912, v61
    v_lshlrev_b32 v10, 5, v8
    v_add_u32 v10, 102656, v10
    s_lshl_b32 s7, s3, 2
    v_add_u32 v11, s7, v10
    s_lshr_b32 s7, s3, 1
    s_lshl_b32 s7, s7, 6
    s_and_b32 s44, s3, 1
    s_lshl_b32 s44, s44, 3
    s_add_u32 s7, s7, s44
    v_add_u32 v62, s7, v69
    s_waitcnt vmcnt(2)
    buffer_load_dwordx4 v7, s[12:15], s36 offen offset:1024 nt lds
    v_bfe_u32 v28, v0, 2, 4
    v_and_b32 v29, 7, v28
    v_lshlrev_b32 v29, 1, v29
    v_bfe_u32 v30, v0, 1, 1
    s_lshl_b32 s7, s3, 1
    v_add_u32 v30, s7, v30
    v_xor_b32 v30, v30, v29
    v_lshlrev_b32 v30, 4, v30
    v_lshl_or_b32 v30, v28, 8, v30
    v_and_b32 v29, 1, v0
    v_lshl_or_b32 v30, v29, 3, v30
    v_add_u32 v63, 65536, v30
    v_lshlrev_b32 v64, 13, v4
    v_lshl_or_b32 v64, v3, 1, v64
    s_lshl_b32 s50, s4, 16
    s_lshl_b32 s7, s5, 5
    s_add_u32 s50, s50, s7
    s_lshl_b32 s7, s3, 10
    s_add_u32 s50, s50, s7
    v_mov_b32 v65, 104192
    s_waitcnt vmcnt(2)
    buffer_load_dwordx4 v6, s[12:15], s36 offen offset:2048 nt lds
    v_lshrrev_b32 v66, 3, v0
    v_lshl_or_b32 v66, v66, 10, v2
    s_lshl_b32 s51, s4, 19
    s_and_b32 s45, s5, 1
    s_lshl_b32 s45, s45, 18
    s_add_u32 s51, s51, s45
    s_lshl_b32 s45, s3, 15
    s_add_u32 s51, s51, s45
    s_lshr_b32 s45, s5, 1
    s_lshl_b32 s45, s45, 7
    s_add_u32 s51, s51, s45
    s_mul_i32 s44, s4, 14
    s_add_u32 s44, s44, s5
    s_sub_u32 s44, s44, 16
    v_lshrrev_b32 v67, 1, v0
    v_mul_u32_u24 v67, 3584, v67
    v_and_b32 v68, 1, v0
    v_lshl_add_u32 v67, v68, 4, v67
    s_mul_i32 s60, s3, 229376
    s_lshl_b32 s45, s44, 5
    s_add_u32 s60, s60, s45
    s_add_u32 s61, s60, 113664
    v_lshlrev_b32 v68, 12, v4
    v_lshl_or_b32 v68, v3, 3, v68
    s_lshl_b32 s53, s44, 14
    s_lshl_b32 s45, s3, 7
    s_add_u32 s53, s53, s45
    s_mov_b32 s41, 1035273459
    s_mov_b32 s42, 1069066811
    s_waitcnt vmcnt(2)
    buffer_load_dwordx4 v7, s[12:15], s36 offen offset:3072 nt lds
    s_mov_b32 m0, s39
    s_waitcnt vmcnt(4)

    ds_read_b128 v[16:19], v12
    ds_read_b128 v[48:51], v13
    ds_read_b128 v[52:55], v14
    ds_read_b128 v[56:59], v15

    s_waitcnt lgkmcnt(0)
    s_barrier

    ds_read_b128 v[20:23], v9
    ds_read_b128 v[24:27], v9 offset:64
    ds_read_b128 v[28:31], v9 offset:128
    ds_read_b128 v[32:35], v9 offset:192
    s_cmp_lt_u32 s5, 16

    s_waitcnt lgkmcnt(3)
    v_mfma_f32_16x16x32_bf16 v[40:43], v[16:19], v[20:23], 0
    s_waitcnt lgkmcnt(2)
    v_mfma_f32_16x16x32_bf16 v[40:43], v[48:51], v[24:27], v[40:43]
    s_waitcnt lgkmcnt(1)
    v_mfma_f32_16x16x32_bf16 v[40:43], v[52:55], v[28:31], v[40:43]
    s_waitcnt lgkmcnt(0)
    v_mfma_f32_16x16x32_bf16 v[40:43], v[56:59], v[32:35], v[40:43]

    s_mov_b32 s46, 4
    s_cmp_lt_u32 s5, 16
    s_cbranch_scc0 L_rl_notwo
    buffer_load_dwordx4 v66, s[20:23], s51 offen offset:0 nt lds
    s_add_u32 s51, s51, 7168
    buffer_load_dwordx4 v66, s[20:23], s51 offen offset:1024 nt lds
    s_add_u32 s51, s51, 7168
    buffer_load_dwordx4 v66, s[20:23], s51 offen offset:2048 nt lds
    s_add_u32 s51, s51, 7168
    buffer_load_dwordx4 v66, s[20:23], s51 offen offset:3072 nt lds
    s_add_u32 s51, s51, 7168
    s_branch L_rl_done
L_rl_notwo:
    s_mov_b32 s46, 0
    s_sub_u32 s45, s5, 16
    s_cmp_lt_u32 s45, 14
    s_cbranch_scc0 L_rl_none
    buffer_load_dwordx2 v[96:97], v68, s[24:27], s53 offen nt
    buffer_load_dwordx2 v[98:99], v68, s[24:27], s53 offen offset:1024 nt
    buffer_load_dwordx2 v[100:101], v68, s[24:27], s53 offen offset:2048 nt
    buffer_load_dwordx2 v[102:103], v68, s[24:27], s53 offen offset:3072 nt
    s_mov_b32 s46, 4
L_rl_none:
L_rl_done:

    s_nop 7

    v_cvt_pk_bf16_f32 v44, v40, v41
    v_cvt_pk_bf16_f32 v45, v42, v43
    v_lshlrev_b32 v40, 16, v44
    v_and_b32 v41, 0xffff0000, v44
    v_lshlrev_b32 v42, 16, v45
    v_and_b32 v43, 0xffff0000, v45
    v_mul_f32 v40, s41, v40
    v_mul_f32 v41, s41, v41
    v_mul_f32 v42, s41, v42
    v_mul_f32 v43, s41, v43
    v_cvt_pk_bf16_f32 v44, v40, v41
    v_cvt_pk_bf16_f32 v45, v42, v43
    v_lshlrev_b32 v40, 16, v44
    v_and_b32 v41, 0xffff0000, v44
    v_lshlrev_b32 v42, 16, v45
    v_and_b32 v43, 0xffff0000, v45
    v_max_f32 v44, v40, v41
    v_max3_f32 v44, v42, v43, v44

    v_mov_b32 v45, v44
    s_nop 1
    v_permlane16_swap_b32 v44, v45
    v_max_f32 v44, v44, v45
    v_mov_b32 v45, v44
    s_nop 1
    v_permlane32_swap_b32 v44, v45
    v_max_f32 v44, v44, v45

    s_mov_b64 exec, 0xf
    ds_write_b32 v11, v44
    s_mov_b64 exec, -1
    s_waitcnt lgkmcnt(0)
    s_barrier
    ds_read_b128 v[20:23], v10
    ds_read_b128 v[24:27], v10 offset:16
    s_waitcnt lgkmcnt(0)
    v_max3_f32 v20, v20, v21, v22
    v_max3_f32 v24, v24, v25, v26
    v_max3_f32 v20, v20, v23, v27
    v_max_f32 v20, v20, v24
    v_mul_f32 v20, s42, v20
    v_fma_f32 v40, v40, s42, -v20
    v_fma_f32 v41, v41, s42, -v20
    v_fma_f32 v42, v42, s42, -v20
    v_fma_f32 v43, v43, s42, -v20
    v_exp_f32 v40, v40
    v_exp_f32 v41, v41
    v_exp_f32 v42, v42
    v_exp_f32 v43, v43
    v_add_f32 v44, v40, v41
    v_cvt_pk_bf16_f32 v46, v40, v41
    v_add_f32 v45, v42, v43
    v_cvt_pk_bf16_f32 v47, v42, v43
    v_add_f32 v44, v44, v45
    s_mov_b64 exec, s[48:49]
    ds_write_b64 v62, v[46:47]
    s_mov_b64 exec, -1

    v_mov_b32 v45, v44
    s_nop 1
    v_permlane16_swap_b32 v44, v45
    v_add_f32 v44, v44, v45
    v_mov_b32 v45, v44
    s_nop 1
    v_permlane32_swap_b32 v44, v45
    v_add_f32 v44, v44, v45

    s_mov_b64 exec, 0xf
    ds_write_b32 v11, v44 offset:128
    s_mov_b64 exec, -1

    s_cmp_eq_u32 s46, 4
    s_cbranch_scc1 L_w4
    s_waitcnt vmcnt(0)
    s_branch L_w1
L_w4:
    s_waitcnt vmcnt(4)
L_w1:
    s_waitcnt lgkmcnt(0)

    s_barrier
    ds_read_b32 v28, v65
    ds_read_b128 v[32:35], v61 offset:0
    ds_read_b64_tr_b16 v[48:49], v63 offset:0
    ds_read_b64_tr_b16 v[50:51], v63 offset:4096
    ds_read_b128 v[36:39], v61 offset:64
    ds_read_b64_tr_b16 v[52:53], v63 offset:8192
    ds_read_b64_tr_b16 v[54:55], v63 offset:12288
    ds_read_b128 v[40:43], v61 offset:128
    ds_read_b64_tr_b16 v[56:57], v63 offset:16384
    ds_read_b64_tr_b16 v[58:59], v63 offset:20480
    ds_read_b128 v[44:47], v61 offset:192
    ds_read_b64_tr_b16 v[60:61], v63 offset:24576
    ds_read_b64_tr_b16 v[62:63], v63 offset:28672
    s_waitcnt lgkmcnt(9)
    v_mfma_f32_16x16x32_bf16 v[20:23], v[32:35], v[48:51], 0
    v_readfirstlane_b32 s63, v28
    s_waitcnt lgkmcnt(6)
    v_mfma_f32_16x16x32_bf16 v[24:27], v[36:39], v[52:55], 0
    s_waitcnt lgkmcnt(3)
    v_mfma_f32_16x16x32_bf16 v[20:23], v[40:43], v[56:59], v[20:23]
    s_waitcnt lgkmcnt(0)
    v_mfma_f32_16x16x32_bf16 v[24:27], v[44:47], v[60:63], v[24:27]

    s_nop 3
    s_add_u32 s7, s50, s63
    s_cmp_eq_u32 s63, 262144
    s_nop 1
    v_add_f32 v20, v20, v24
    s_nop 1
    v_mov_b32_dpp v21, v20 quad_perm:[1,0,3,2] row_mask:0xf bank_mask:0xf
    s_mov_b32 exec_lo, 0x55555555
    s_mov_b32 exec_hi, 0x55555555
    v_cvt_pk_bf16_f32 v20, v20, v21
    v_min_u32 v20, -2, v20
    s_cbranch_scc0 L_pubB
    buffer_store_dword v20, v64, s[28:31], s7 offen
    s_branch L_pubE
L_pubB:
    buffer_store_dword v20, v64, s[28:31], s7 offen sc1
L_pubE:
    s_mov_b64 exec, -1

    s_cmp_lt_u32 s5, 16
    s_cbranch_scc1 L_wo
    s_cmp_lt_u32 s5, 30
    s_cbranch_scc0 L_fin
    s_barrier
    s_branch L_mlp

L_comm:

    v_lshlrev_b32 v2, 4, v0
    s_lshl_b32 s50, s4, 5
    s_add_u32 s50, s50, s5
    s_lshl_b32 s51, s4, 16
    s_lshl_b32 s7, s5, 3
    s_add_u32 s51, s51, s7
    s_add_u32 s51, s51, 32768
    s_waitcnt lgkmcnt(0)
    global_load_dwordx4 v[8:11], v2, s[32:33]
    s_load_dword s43, s[28:29], 0x0

    s_barrier

    v_and_b32 v3, 15, v0
    v_lshrrev_b32 v4, 4, v0
    v_lshlrev_b32 v15, 8, v4
    v_lshl_or_b32 v15, v3, 4, v15
    v_add_u32 v14, 99328, v15
    s_lshl_b32 s55, s4, 13
    s_add_u32 s55, s55, 4096
    s_lshl_b32 s7, s5, 8
    s_add_u32 s57, s55, s7
    s_add_u32 s58, s57, 65536
    s_add_u32 s55, s55, 65536
    s_mov_b32 s53, 0x0c0c0400
    s_mov_b32 s54, 0x04000c0c
    v_lshlrev_b32 v16, 4, v3
    v_lshrrev_b32 v17, 1, v4
    v_mul_u32_u24 v17, 320, v17
    v_and_b32 v18, 1, v4
    v_lshl_add_u32 v17, v18, 7, v17
    v_lshl_add_u32 v17, v3, 3, v17
    v_add_u32 v17, 101376, v17
    v_add_u32 v3, 98304, v2
    s_waitcnt vmcnt(0)

    v_lshlrev_b32 v20, 16, v8
    v_and_b32 v21, 0xffff0000, v8
    v_lshlrev_b32 v22, 16, v9
    v_and_b32 v23, 0xffff0000, v9
    v_lshlrev_b32 v24, 16, v10
    v_and_b32 v25, 0xffff0000, v10
    v_lshlrev_b32 v26, 16, v11
    v_and_b32 v27, 0xffff0000, v11

    v_add_f32 v28, v20, v21
    v_add_f32 v29, v22, v23
    v_add_f32 v30, v24, v25
    v_add_f32 v31, v26, v27
    v_add_f32 v28, v28, v29
    v_add_f32 v30, v30, v31
    v_add_f32 v28, v28, v30

    s_nop 1
    v_add_f32_dpp v28, v28, v28 row_ror:8 row_mask:0xf bank_mask:0xf
    s_nop 1
    v_add_f32_dpp v28, v28, v28 row_ror:4 row_mask:0xf bank_mask:0xf
    s_nop 1
    v_add_f32_dpp v28, v28, v28 row_ror:2 row_mask:0xf bank_mask:0xf
    s_nop 1
    v_add_f32_dpp v28, v28, v28 row_ror:1 row_mask:0xf bank_mask:0xf
    v_mov_b32 v29, v28
    s_nop 1
    v_permlane16_swap_b32 v28, v29
    v_add_f32 v28, v28, v29
    v_mov_b32 v29, v28
    s_nop 1
    v_permlane32_swap_b32 v28, v29
    v_add_f32 v28, v28, v29
    v_mul_f32 v28, 0x3b000000, v28
    v_sub_f32 v32, v20, v28
    v_sub_f32 v33, v21, v28
    v_sub_f32 v34, v22, v28
    v_sub_f32 v35, v23, v28
    v_sub_f32 v36, v24, v28
    v_sub_f32 v37, v25, v28
    v_sub_f32 v38, v26, v28
    v_sub_f32 v39, v27, v28
    v_mul_f32 v29, v32, v32
    v_mul_f32 v30, v33, v33
    v_fmac_f32 v29, v34, v34
    v_fmac_f32 v30, v35, v35
    v_fmac_f32 v29, v36, v36
    v_fmac_f32 v30, v37, v37
    v_fmac_f32 v29, v38, v38
    v_fmac_f32 v30, v39, v39
    v_add_f32 v29, v29, v30
    s_nop 1
    v_add_f32_dpp v29, v29, v29 row_ror:8 row_mask:0xf bank_mask:0xf
    s_nop 1
    v_add_f32_dpp v29, v29, v29 row_ror:4 row_mask:0xf bank_mask:0xf
    s_nop 1
    v_add_f32_dpp v29, v29, v29 row_ror:2 row_mask:0xf bank_mask:0xf
    s_nop 1
    v_add_f32_dpp v29, v29, v29 row_ror:1 row_mask:0xf bank_mask:0xf
    v_mov_b32 v30, v29
    s_nop 1
    v_permlane16_swap_b32 v29, v30
    v_add_f32 v29, v29, v30
    v_mov_b32 v30, v29
    s_nop 1
    v_permlane32_swap_b32 v29, v30
    v_add_f32 v29, v29, v30

    v_mul_f32 v29, 0x3b000000, v29
    v_cvt_pk_bf16_f32 v30, v28, v29
    v_lshlrev_b32 v28, 16, v30
    v_and_b32 v29, 0xffff0000, v30
    v_add_f32 v29, 0x3727c5ac, v29
    v_cvt_pk_bf16_f32 v29, v29, v29
    v_and_b32 v29, 0xffff0000, v29
    v_sqrt_f32 v29, v29
    s_nop 0
    v_cvt_pk_bf16_f32 v29, v29, v29
    v_and_b32 v29, 0xffff0000, v29
    v_rcp_f32 v30, v29

    v_sub_f32 v32, v20, v28
    v_sub_f32 v33, v21, v28
    v_sub_f32 v34, v22, v28
    v_sub_f32 v35, v23, v28
    v_sub_f32 v36, v24, v28
    v_sub_f32 v37, v25, v28
    v_sub_f32 v38, v26, v28
    v_sub_f32 v39, v27, v28
    v_cvt_pk_bf16_f32 v40, v32, v33
    v_cvt_pk_bf16_f32 v41, v34, v35
    v_cvt_pk_bf16_f32 v42, v36, v37
    v_cvt_pk_bf16_f32 v43, v38, v39
    v_lshlrev_b32 v32, 16, v40
    v_and_b32 v33, 0xffff0000, v40
    v_lshlrev_b32 v34, 16, v41
    v_and_b32 v35, 0xffff0000, v41
    v_lshlrev_b32 v36, 16, v42
    v_and_b32 v37, 0xffff0000, v42
    v_lshlrev_b32 v38, 16, v43
    v_and_b32 v39, 0xffff0000, v43
    v_mul_f32 v20, v32, v30
    v_mul_f32 v21, v33, v30
    v_mul_f32 v22, v34, v30
    v_mul_f32 v23, v35, v30
    v_mul_f32 v24, v36, v30
    v_mul_f32 v25, v37, v30
    v_mul_f32 v26, v38, v30
    v_mul_f32 v27, v39, v30
    v_fma_f32 v40, -v20, v29, v32
    v_fma_f32 v41, -v21, v29, v33
    v_fma_f32 v42, -v22, v29, v34
    v_fma_f32 v43, -v23, v29, v35
    v_fma_f32 v44, -v24, v29, v36
    v_fma_f32 v45, -v25, v29, v37
    v_fma_f32 v46, -v26, v29, v38
    v_fma_f32 v47, -v27, v29, v39
    v_fmac_f32 v20, v40, v30
    v_fmac_f32 v21, v41, v30
    v_fmac_f32 v22, v42, v30
    v_fmac_f32 v23, v43, v30
    v_fmac_f32 v24, v44, v30
    v_fmac_f32 v25, v45, v30
    v_fmac_f32 v26, v46, v30
    v_fmac_f32 v27, v47, v30
    v_cvt_pk_bf16_f32 v40, v20, v21
    v_cvt_pk_bf16_f32 v41, v22, v23
    v_cvt_pk_bf16_f32 v42, v24, v25
    v_cvt_pk_bf16_f32 v43, v26, v27

    ds_write_b128 v3, v[40:43]
    s_waitcnt lgkmcnt(0)

    s_barrier
    s_mul_i32 s42, s43, 0x9e3779b1
    s_add_u32 s42, s42, 0x7f4a7c15
    s_bfe_u32 s44, s42, 524288
    s_bfe_u32 s45, s42, 524296
    s_bfe_u32 s46, s42, 524304
    s_bfe_u32 s47, s42, 524312
    v_mov_b32 v72, s44
    v_mov_b32 v73, s45
    v_mov_b32 v74, s46
    v_mov_b32 v75, s47
    s_mov_b32 s44, 0xffffff00
    s_getreg_b32 s6, hwreg(HW_REG_XCC_ID, 0, 3)
    s_and_b32 s40, s42, 0xfffffff8
    s_or_b32 s41, s40, s6
    s_mov_b32 s59, 139264
    s_mov_b32 s61, 0xfffffff8
    s_setprio 3
    s_barrier
    ds_read_b128 v[20:23], v14
    ds_read_b128 v[24:27], v14 offset:1024
    s_waitcnt lgkmcnt(0)

    v_pk_add_f32 v[20:21], v[20:21], v[24:25]
    v_pk_add_f32 v[22:23], v[22:23], v[26:27]
    v_mov_b32 v24, v20
    v_mov_b32 v25, v21
    v_mov_b32 v26, v22
    v_mov_b32 v27, v23
    s_nop 0
    v_permlane16_swap_b32 v20, v24
    v_permlane16_swap_b32 v21, v25
    v_permlane16_swap_b32 v22, v26
    v_permlane16_swap_b32 v23, v27
    v_add_f32 v20, v20, v24
    v_add_f32 v21, v21, v25
    v_add_f32 v22, v22, v26
    v_add_f32 v23, v23, v27
    v_mov_b32 v24, v20
    v_mov_b32 v25, v21
    v_mov_b32 v26, v22
    v_mov_b32 v27, v23
    s_nop 0
    v_permlane32_swap_b32 v20, v24
    v_permlane32_swap_b32 v21, v25
    v_permlane32_swap_b32 v22, v26
    v_permlane32_swap_b32 v23, v27
    v_add_f32 v20, v20, v24
    v_add_f32 v21, v21, v25
    v_add_f32 v22, v22, v26
    v_add_f32 v23, v23, v27
    v_add_u32 v20, 0x80, v20
    v_add_u32 v21, 0x80, v21
    v_add_u32 v22, 0x80, v22
    v_add_u32 v23, 0x80, v23
    v_and_or_b32 v20, v20, s44, v72
    v_and_or_b32 v21, v21, s44, v73
    v_and_or_b32 v22, v22, s44, v74
    v_and_or_b32 v23, v23, s44, v75

    s_mov_b64 exec, 0xffff
    buffer_store_dwordx4 v[20:23], v16, s[28:31], s58 offen
    buffer_store_dwordx4 v[20:23], v16, s[28:31], s57 offen sc1
    s_mov_b64 exec, -1

    s_mov_b32 s52, 40000
L_q_poll:
    s_cmp_eq_u32 s52, 39992
    s_cbranch_scc0 L_q_same
    s_lshl_b32 s55, s4, 13
    s_add_u32 s55, s55, 4096
L_q_same:
    s_add_u32 s56, s55, 4096
    buffer_load_dwordx4 v[32:35], v15, s[28:31], s55 offen offset:0 sc1
    buffer_load_dwordx4 v[36:39], v15, s[28:31], s55 offen offset:1024 sc1
    buffer_load_dwordx4 v[40:43], v15, s[28:31], s55 offen offset:2048 sc1
    buffer_load_dwordx4 v[44:47], v15, s[28:31], s55 offen offset:3072 sc1
    buffer_load_dwordx4 v[48:51], v15, s[28:31], s56 offen offset:0 sc1
    buffer_load_dwordx4 v[52:55], v15, s[28:31], s56 offen offset:1024 sc1
    buffer_load_dwordx4 v[56:59], v15, s[28:31], s56 offen offset:2048 sc1
    buffer_load_dwordx4 v[60:63], v15, s[28:31], s56 offen offset:3072 sc1
    s_waitcnt vmcnt(0)
    v_perm_b32 v68, v33, v32, s53
    v_perm_b32 v69, v35, v34, s54
    v_or_b32 v70, v68, v69
    v_xor_b32 v70, s42, v70
    v_perm_b32 v68, v37, v36, s53
    v_perm_b32 v69, v39, v38, s54
    v_or_b32 v68, v68, v69
    v_xor_b32 v68, s42, v68
    v_or_b32 v70, v70, v68
    v_perm_b32 v68, v41, v40, s53
    v_perm_b32 v69, v43, v42, s54
    v_or_b32 v68, v68, v69
    v_xor_b32 v68, s42, v68
    v_or_b32 v70, v70, v68
    v_perm_b32 v68, v45, v44, s53
    v_perm_b32 v69, v47, v46, s54
    v_or_b32 v68, v68, v69
    v_xor_b32 v68, s42, v68
    v_or_b32 v70, v70, v68
    v_perm_b32 v68, v49, v48, s53
    v_perm_b32 v69, v51, v50, s54
    v_or_b32 v68, v68, v69
    v_xor_b32 v68, s42, v68
    v_or_b32 v70, v70, v68
    v_perm_b32 v68, v53, v52, s53
    v_perm_b32 v69, v55, v54, s54
    v_or_b32 v68, v68, v69
    v_xor_b32 v68, s42, v68
    v_or_b32 v70, v70, v68
    v_perm_b32 v68, v57, v56, s53
    v_perm_b32 v69, v59, v58, s54
    v_or_b32 v68, v68, v69
    v_xor_b32 v68, s42, v68
    v_or_b32 v70, v70, v68
    v_perm_b32 v68, v61, v60, s53
    v_perm_b32 v69, v63, v62, s54
    v_or_b32 v68, v68, v69
    v_xor_b32 v68, s42, v68
    v_or_b32 v70, v70, v68
    v_cmp_ne_u32 vcc, 0, v70
    s_cbranch_vccz L_q_ok
    s_sub_u32 s52, s52, 1
    s_cbranch_scc0 L_q_poll
L_q_ok:
    v_and_b32 v32, s44, v32
    v_and_b32 v33, s44, v33
    v_and_b32 v34, s44, v34
    v_and_b32 v35, s44, v35
    v_and_b32 v36, s44, v36
    v_and_b32 v37, s44, v37
    v_and_b32 v38, s44, v38
    v_and_b32 v39, s44, v39
    v_and_b32 v40, s44, v40
    v_and_b32 v41, s44, v41
    v_and_b32 v42, s44, v42
    v_and_b32 v43, s44, v43
    v_and_b32 v44, s44, v44
    v_and_b32 v45, s44, v45
    v_and_b32 v46, s44, v46
    v_and_b32 v47, s44, v47
    v_and_b32 v48, s44, v48
    v_and_b32 v49, s44, v49
    v_and_b32 v50, s44, v50
    v_and_b32 v51, s44, v51
    v_and_b32 v52, s44, v52
    v_and_b32 v53, s44, v53
    v_and_b32 v54, s44, v54
    v_and_b32 v55, s44, v55
    v_and_b32 v56, s44, v56
    v_and_b32 v57, s44, v57
    v_and_b32 v58, s44, v58
    v_and_b32 v59, s44, v59
    v_and_b32 v60, s44, v60
    v_and_b32 v61, s44, v61
    v_and_b32 v62, s44, v62
    v_and_b32 v63, s44, v63
    v_pk_add_f32 v[32:33], v[32:33], v[40:41]
    v_pk_add_f32 v[48:49], v[48:49], v[56:57]
    v_pk_add_f32 v[34:35], v[34:35], v[42:43]
    v_pk_add_f32 v[50:51], v[50:51], v[58:59]
    v_pk_add_f32 v[32:33], v[32:33], v[48:49]
    v_pk_add_f32 v[34:35], v[34:35], v[50:51]
    v_pk_add_f32 v[36:37], v[36:37], v[44:45]
    v_pk_add_f32 v[52:53], v[52:53], v[60:61]
    v_pk_add_f32 v[38:39], v[38:39], v[46:47]
    v_pk_add_f32 v[54:55], v[54:55], v[62:63]
    v_pk_add_f32 v[36:37], v[36:37], v[52:53]
    v_pk_add_f32 v[38:39], v[38:39], v[54:55]
    v_cvt_pk_bf16_f32 v20, v32, v33
    v_cvt_pk_bf16_f32 v21, v34, v35
    v_cvt_pk_bf16_f32 v22, v36, v37
    v_cvt_pk_bf16_f32 v23, v38, v39
L_q_tail:

    ds_write_b64 v17, v[20:21]
    ds_write_b64 v17, v[22:23] offset:640

    s_waitcnt lgkmcnt(0)
    s_barrier
    v_and_b32 v12, 3, v0
    v_lshlrev_b32 v13, 5, v12
    v_add_u32 v13, 102656, v13
    v_lshlrev_b32 v14, 8, v12
    v_mov_b32 v15, 104192
    s_barrier
    s_waitcnt vmcnt(0)
    s_barrier
    ds_read_b32 v16, v15
    ds_read_b128 v[20:23], v13
    ds_read_b128 v[24:27], v13 offset:16
    ds_read_b128 v[28:31], v13 offset:128
    ds_read_b128 v[32:35], v13 offset:144
    s_waitcnt lgkmcnt(0)
    v_readfirstlane_b32 s63, v16
    v_max3_f32 v20, v20, v21, v22
    v_max3_f32 v24, v24, v25, v26
    v_add_f32 v28, v28, v29
    v_add_f32 v30, v30, v31
    v_add_f32 v32, v32, v33
    v_add_f32 v34, v34, v35
    v_max3_f32 v20, v20, v23, v27
    v_add_f32 v28, v28, v30
    v_add_f32 v32, v32, v34
    v_max_f32 v20, v20, v24
    v_add_f32 v21, v28, v32
    s_add_u32 s7, s51, s63
    s_cmp_eq_u32 s63, 262144
    s_mov_b64 exec, 0xf
    s_cbranch_scc0 L_stB
    buffer_store_dwordx2 v[20:21], v14, s[28:31], s7 offen
    s_branch L_stE
L_stB:
    buffer_store_dwordx2 v[20:21], v14, s[28:31], s7 offen sc1
L_stE:
    s_mov_b64 exec, -1

    s_endpgm
L_help:

    v_lshlrev_b32 v2, 4, v0
    s_getreg_b32 s6, hwreg(HW_REG_XCC_ID, 0, 3)
    s_lshl_b32 s50, s4, 5
    s_add_u32 s50, s50, s5
    s_lshl_b32 s51, s50, 11
    v_mov_b32 v12, -1
    v_mov_b32 v13, -1
    v_mov_b32 v14, -1
    v_mov_b32 v15, -1
    s_lshl_b32 s51, s4, 16
    s_lshl_b32 s7, s5, 5
    s_add_u32 s53, s51, s7
    s_add_u32 s54, s53, 786432
    s_add_u32 s53, s53, 262144
    s_lshl_b32 s7, s5, 3
    s_add_u32 s55, s51, s7
    s_add_u32 s56, s55, 819200
    s_add_u32 s55, s55, 294912
    v_lshrrev_b32 v6, 1, v0
    v_lshlrev_b32 v6, 10, v6
    v_and_b32 v7, 1, v0
    v_lshl_or_b32 v6, v7, 4, v6
    v_lshlrev_b32 v7, 8, v0
    s_lshl_b32 s7, s50, 8
    s_add_u32 s57, s7, 69632
    s_barrier
    s_waitcnt lgkmcnt(0)
    s_load_dword s43, s[28:29], 0x0
    s_mov_b64 exec, 0xffff
    buffer_load_dwordx4 v[80:83], v2, s[28:31], s57 offen sc1
    s_mov_b64 exec, -1

    s_getpc_b64 s[44:45]
L_pc:
    s_sub_u32 s44, s44, L_pc-sequential_preLN__sliding_block_cached__dense_activation_silu__decode_kernel
    s_subb_u32 s45, s45, 0
    s_lshl_b32 s7, s5, 9
    v_add_u32 v3, s7, v2
    s_mov_b32 s7, L_exit-sequential_preLN__sliding_block_cached__dense_activation_silu__decode_kernel-16
    v_min_u32 v3, s7, v3
    s_mov_b32 exec_hi, 0
    global_load_dwordx4 v[84:87], v3, s[44:45]
    s_mov_b64 exec, -1

    buffer_store_dwordx4 v[12:15], v6, s[28:31], s53 offen
    s_mov_b64 exec, 0xf
    buffer_store_dwordx2 v[12:13], v7, s[28:31], s55 offen
    s_mov_b64 exec, -1
    s_cmp_lt_u32 s5, 16
    s_cbranch_scc0 L_cl_notwo
    v_lshrrev_b32 v3, 3, v0
    v_lshlrev_b32 v3, 15, v3
    v_and_b32 v4, 7, v0
    v_lshl_or_b32 v3, v4, 4, v3
    s_lshl_b32 s7, s4, 1
    s_and_b32 s44, s5, 1
    s_add_u32 s7, s7, s44
    s_lshl_b32 s7, s7, 11
    s_lshr_b32 s44, s5, 1
    s_lshl_b32 s44, s44, 8
    s_add_u32 s7, s7, s44
    s_add_u32 s7, s7, 1310720
    buffer_store_dwordx4 v[12:15], v3, s[28:31], s7 offen sc1
    buffer_store_dwordx4 v[12:15], v3, s[28:31], s7 offen offset:128 sc1
    s_branch L_cl_done
L_cl_notwo:
    s_cmp_lt_u32 s5, 30
    s_cbranch_scc0 L_cl_done
    s_mul_i32 s7, s4, 14
    s_add_u32 s7, s7, s5
    s_sub_u32 s7, s7, 16
    s_lshl_b32 s7, s7, 11
    s_add_u32 s7, s7, 1572864
    buffer_store_dwordx4 v[12:15], v2, s[28:31], s7 offen sc1
    buffer_store_dwordx4 v[12:15], v2, s[28:31], s7 offen offset:1024 sc1
L_cl_done:
    s_lshl_b32 s7, s5, 10
    s_add_u32 s7, s7, s51
    s_add_u32 s7, s7, 262144
    buffer_load_dwordx4 v[72:75], v2, s[28:31], s7 offen sc1
    s_and_b32 s7, s5, 7
    s_lshl_b32 s7, s7, 7
    s_add_u32 s7, s7, s51
    s_add_u32 s7, s7, 294912
    s_mov_b64 exec, 1
    buffer_load_dwordx4 v[76:79], v2, s[28:31], s7 offen sc1
    s_mov_b64 exec, -1
    s_waitcnt lgkmcnt(0)
    s_mul_i32 s42, s43, 0x9e3779b1
    s_add_u32 s42, s42, 0x7f4a7c15
    s_and_b32 s40, s42, 0xfffffff8
    s_or_b32 s41, s40, s6
    v_mov_b32 v4, s41
    s_lshl_b32 s7, s50, 7
    s_add_u32 s57, s7, 139264
    v_mov_b32 v5, 0
    s_barrier
    s_barrier
    s_waitcnt vmcnt(0)
    s_mov_b64 exec, 1
    buffer_store_dword v4, v5, s[28:31], s57 offen sc1
    s_mov_b64 exec, -1

    v_and_b32 v8, 31, v0
    v_lshlrev_b32 v8, 7, v8
    s_lshl_b32 s7, s4, 12
    s_add_u32 s58, s7, 139264
    s_barrier

    buffer_load_dword v64, v8, s[28:31], s58 offen sc1

    s_barrier
    s_mov_b32 s52, 40000
L_x_poll:
    s_waitcnt vmcnt(0)
    v_xor_b32 v68, s40, v64
    v_and_b32 v68, 0xfffffff8, v68
    v_cmp_ne_u32 vcc, 0, v68
    s_cbranch_vccz L_x_ok
    s_sub_u32 s52, s52, 1
    s_cbranch_scc1 L_x_ok
    buffer_load_dword v64, v8, s[28:31], s58 offen sc1
    s_branch L_x_poll
L_x_ok:
    v_cmp_ne_u32 vcc, s41, v64
    s_or_b32 s44, vcc_lo, vcc_hi
    s_mov_b32 s63, 262144
    s_cmp_eq_u32 s44, 0
    s_cbranch_scc1 L_x_pure
    buffer_store_dwordx4 v[12:15], v6, s[28:31], s54 offen sc1
    s_mov_b64 exec, 0xf
    buffer_store_dwordx2 v[12:13], v7, s[28:31], s56 offen sc1
    s_mov_b64 exec, -1
    s_waitcnt vmcnt(0)
    s_mov_b64 exec, 1
    buffer_store_dword v4, v5, s[28:31], s57 offen offset:64 sc1
    s_mov_b64 exec, -1
    s_mov_b32 s52, 40000
L_y_poll:
    buffer_load_dword v64, v8, s[28:31], s58 offen offset:64 sc1
    s_waitcnt vmcnt(0)
    v_xor_b32 v68, s40, v64
    v_and_b32 v68, 0xfffffff8, v68
    v_cmp_ne_u32 vcc, 0, v68
    s_cbranch_vccz L_y_ok
    s_sub_u32 s52, s52, 1
    s_cbranch_scc0 L_y_poll
L_y_ok:
    s_mov_b32 s63, 786432
L_x_pure:
    v_mov_b32 v25, 104192
    v_mov_b32 v26, s63
    ds_write_b32 v25, v26
    s_waitcnt lgkmcnt(0)

    s_barrier
    s_endpgm
L_wo:

    v_and_b32 v8, 31, v0
    v_lshrrev_b32 v9, 5, v0
    v_lshlrev_b32 v10, 3, v8
    v_lshlrev_b32 v11, 5, v8
    v_lshl_or_b32 v11, v9, 4, v11
    s_lshl_b32 s7, s4, 16
    s_add_u32 s7, s7, s63
    s_and_b32 s44, s5, 1
    s_lshl_b32 s44, s44, 1
    s_lshr_b32 s45, s3, 2
    s_add_u32 s44, s44, s45
    s_lshl_b32 s45, s44, 13
    s_and_b32 s46, s3, 3
    s_lshl_b32 s46, s46, 11
    s_add_u32 s45, s45, s46
    s_add_u32 s55, s7, s45
    s_lshl_b32 s44, s44, 8
    s_add_u32 s56, s7, s44
    s_add_u32 s56, s56, 32768
    v_bfe_u32 v12, v0, 4, 1
    v_bfe_u32 v13, v0, 2, 2
    v_bfe_u32 v14, v0, 1, 1
    v_lshl_or_b32 v14, v12, 1, v14
    v_and_b32 v16, 2, v13
    v_xor_b32 v17, v14, v16
    v_lshlrev_b32 v15, 10, v9
    v_lshl_or_b32 v15, v13, 7, v15
    v_and_b32 v16, 1, v0
    v_lshl_or_b32 v15, v16, 3, v15
    v_add_u32 v15, s39, v15
    v_lshl_add_u32 v18, v17, 4, v15
    v_xor_b32 v19, 64, v18
    s_lshl_b32 s7, s3, 8
    s_add_u32 s7, s7, 104256
    v_lshlrev_b32 v24, 2, v0
    v_add_u32 v24, s7, v24
    v_and_b32 v25, 7, v0
    v_lshlrev_b32 v25, 4, v25
    s_lshl_b32 s44, s3, 7
    s_add_u32 s7, s44, 104256
    v_bfe_u32 v26, v0, 3, 2
    v_lshl_add_u32 v26, v26, 8, v25
    v_add_u32 v26, s7, v26
    v_lshrrev_b32 v27, 3, v0
    v_lshlrev_b32 v27, 15, v27
    v_add_u32 v27, v27, v25
    s_lshl_b32 s7, s4, 1
    s_and_b32 s45, s5, 1
    s_add_u32 s7, s7, s45
    s_lshl_b32 s7, s7, 11
    s_lshr_b32 s45, s5, 1
    s_lshl_b32 s45, s45, 8
    s_add_u32 s7, s7, s45
    s_add_u32 s7, s7, s44
    s_add_u32 s57, s7, 1310720

    s_mov_b32 s52, 40000
L_wo_ps:
    buffer_load_dwordx2 v[16:17], v10, s[28:31], s56 offen sc1
    s_waitcnt vmcnt(0)
    v_max3_u32 v20, v16, v17, v17
    v_cmp_eq_u32 vcc, -1, v20
    s_and_b64 exec, exec, vcc
    s_cbranch_scc0 L_wo_ps_ok
    s_sub_u32 s52, s52, 1
    s_cbranch_scc0 L_wo_ps
L_wo_ps_ok:
    s_mov_b64 exec, -1
    ds_read_b64_tr_b16 v[48:49], v18 offset:0
    ds_read_b64_tr_b16 v[50:51], v19 offset:512
    ds_read_b64_tr_b16 v[52:53], v19 offset:0
    ds_read_b64_tr_b16 v[54:55], v18 offset:512
    ds_read_b64_tr_b16 v[56:57], v18 offset:2048
    ds_read_b64_tr_b16 v[58:59], v19 offset:2560
    ds_read_b64_tr_b16 v[60:61], v19 offset:2048
    ds_read_b64_tr_b16 v[62:63], v18 offset:2560

    buffer_load_dwordx4 v[32:35], v11, s[28:31], s55 offen sc1
    buffer_load_dwordx4 v[36:39], v11, s[28:31], s55 offen offset:1024 sc1

    v_mov_b32 v20, v16
    s_nop 1
    v_max_f32_dpp v20, v20, v20 row_ror:8 row_mask:0xf bank_mask:0xf
    s_nop 1
    v_max_f32_dpp v20, v20, v20 row_ror:4 row_mask:0xf bank_mask:0xf
    s_nop 1
    v_max_f32_dpp v20, v20, v20 row_ror:2 row_mask:0xf bank_mask:0xf
    s_nop 1
    v_max_f32_dpp v20, v20, v20 row_ror:1 row_mask:0xf bank_mask:0xf
    v_mov_b32 v21, v20
    s_nop 1
    v_permlane16_swap_b32 v20, v21
    v_max_f32 v20, v20, v21

    v_sub_f32 v16, v16, v20
    v_mul_f32 v16, s42, v16
    v_exp_f32 v16, v16
    s_nop 0
    v_mul_f32 v17, v16, v17
    v_mov_b32 v21, v16
    s_nop 1
    v_permlane16_swap_b32 v16, v21
    s_nop 1
    v_mov_b32_dpp v16, v16 row_ror:12 row_mask:0xc bank_mask:0xf
    v_mov_b32_dpp v21, v21 row_ror:12 row_mask:0xc bank_mask:0xf

    s_mov_b32 s52, 40000
L_wo_po:
    s_waitcnt vmcnt(0)
    v_max3_u32 v22, v32, v33, v34
    v_max3_u32 v23, v35, v36, v37
    v_max3_u32 v22, v22, v38, v39
    v_max_u32 v22, v22, v23

    v_cmp_eq_u32 vcc, -1, v22
    s_and_b64 exec, exec, vcc
    s_cbranch_scc0 L_wo_po_ok
    s_sub_u32 s52, s52, 1
    s_cbranch_scc1 L_wo_po_ok
    buffer_load_dwordx4 v[32:35], v11, s[28:31], s55 offen sc1
    buffer_load_dwordx4 v[36:39], v11, s[28:31], s55 offen offset:1024 sc1
    s_branch L_wo_po
L_wo_po_ok:
    s_mov_b64 exec, -1

    s_waitcnt lgkmcnt(0)
    v_mfma_f32_32x32x16_bf16 v[64:79], v[32:35], v[48:51], 0
    v_mfma_f32_32x32x16_bf16 v[64:79], v[36:39], v[56:59], v[64:79]
    v_mfma_f32_32x32x16_bf16 v[80:95], v[32:35], v[52:55], 0
    v_mfma_f32_32x32x16_bf16 v[80:95], v[36:39], v[60:63], v[80:95]

    s_nop 1
    v_add_f32_dpp v17, v17, v17 row_ror:8 row_mask:0xf bank_mask:0xf
    s_nop 1
    v_add_f32_dpp v17, v17, v17 row_ror:4 row_mask:0xf bank_mask:0xf
    s_nop 1
    v_add_f32_dpp v17, v17, v17 row_ror:2 row_mask:0xf bank_mask:0xf
    s_nop 1
    v_add_f32_dpp v17, v17, v17 row_ror:1 row_mask:0xf bank_mask:0xf
    v_mov_b32 v22, v17
    s_nop 1
    v_permlane16_swap_b32 v17, v22
    v_add_f32 v17, v17, v22
    v_rcp_f32 v17, v17
    v_mul_f32_dpp v40, v16, v64 row_newbcast:0 row_mask:0xf bank_mask:0xf
    v_mul_f32_dpp v42, v16, v80 row_newbcast:0 row_mask:0xf bank_mask:0xf
    v_mul_f32_dpp v41, v16, v65 row_newbcast:1 row_mask:0xf bank_mask:0xf
    v_mul_f32_dpp v43, v16, v81 row_newbcast:1 row_mask:0xf bank_mask:0xf
    v_fmac_f32_dpp v40, v16, v66 row_newbcast:2 row_mask:0xf bank_mask:0xf
    v_fmac_f32_dpp v42, v16, v82 row_newbcast:2 row_mask:0xf bank_mask:0xf
    v_fmac_f32_dpp v41, v16, v67 row_newbcast:3 row_mask:0xf bank_mask:0xf
    v_fmac_f32_dpp v43, v16, v83 row_newbcast:3 row_mask:0xf bank_mask:0xf
    v_fmac_f32_dpp v40, v16, v68 row_newbcast:8 row_mask:0xf bank_mask:0xf
    v_fmac_f32_dpp v42, v16, v84 row_newbcast:8 row_mask:0xf bank_mask:0xf
    v_fmac_f32_dpp v41, v16, v69 row_newbcast:9 row_mask:0xf bank_mask:0xf
    v_fmac_f32_dpp v43, v16, v85 row_newbcast:9 row_mask:0xf bank_mask:0xf
    v_fmac_f32_dpp v40, v16, v70 row_newbcast:10 row_mask:0xf bank_mask:0xf
    v_fmac_f32_dpp v42, v16, v86 row_newbcast:10 row_mask:0xf bank_mask:0xf
    v_fmac_f32_dpp v41, v16, v71 row_newbcast:11 row_mask:0xf bank_mask:0xf
    v_fmac_f32_dpp v43, v16, v87 row_newbcast:11 row_mask:0xf bank_mask:0xf
    v_fmac_f32_dpp v40, v21, v72 row_newbcast:0 row_mask:0xf bank_mask:0xf
    v_fmac_f32_dpp v42, v21, v88 row_newbcast:0 row_mask:0xf bank_mask:0xf
    v_fmac_f32_dpp v41, v21, v73 row_newbcast:1 row_mask:0xf bank_mask:0xf
    v_fmac_f32_dpp v43, v21, v89 row_newbcast:1 row_mask:0xf bank_mask:0xf
    v_fmac_f32_dpp v40, v21, v74 row_newbcast:2 row_mask:0xf bank_mask:0xf
    v_fmac_f32_dpp v42, v21, v90 row_newbcast:2 row_mask:0xf bank_mask:0xf
    v_fmac_f32_dpp v41, v21, v75 row_newbcast:3 row_mask:0xf bank_mask:0xf
    v_fmac_f32_dpp v43, v21, v91 row_newbcast:3 row_mask:0xf bank_mask:0xf
    v_fmac_f32_dpp v40, v21, v76 row_newbcast:8 row_mask:0xf bank_mask:0xf
    v_fmac_f32_dpp v42, v21, v92 row_newbcast:8 row_mask:0xf bank_mask:0xf
    v_fmac_f32_dpp v41, v21, v77 row_newbcast:9 row_mask:0xf bank_mask:0xf
    v_fmac_f32_dpp v43, v21, v93 row_newbcast:9 row_mask:0xf bank_mask:0xf
    v_fmac_f32_dpp v40, v21, v78 row_newbcast:10 row_mask:0xf bank_mask:0xf
    v_fmac_f32_dpp v42, v21, v94 row_newbcast:10 row_mask:0xf bank_mask:0xf
    v_fmac_f32_dpp v41, v21, v79 row_newbcast:11 row_mask:0xf bank_mask:0xf
    v_fmac_f32_dpp v43, v21, v95 row_newbcast:11 row_mask:0xf bank_mask:0xf

    v_add_f32 v40, v40, v41
    v_add_f32 v42, v42, v43
    s_nop 1
    v_permlane32_swap_b32 v40, v42
    v_add_f32 v40, v40, v42
    v_mul_f32 v40, v40, v17
    ds_write_b32 v24, v40
    s_waitcnt lgkmcnt(0)

    s_barrier

    s_cmp_gt_u32 s3, 1
    s_cbranch_scc1 L_wo_end

    ds_read_b128 v[32:35], v26
    ds_read_b128 v[36:39], v26 offset:1024
    s_waitcnt lgkmcnt(0)
    v_pk_add_f32 v[32:33], v[32:33], v[36:37]
    v_pk_add_f32 v[34:35], v[34:35], v[38:39]
    s_nop 0
    v_add_f32_dpp v32, v32, v32 row_ror:8 row_mask:0xf bank_mask:0xf
    v_add_f32_dpp v33, v33, v33 row_ror:8 row_mask:0xf bank_mask:0xf
    v_add_f32_dpp v34, v34, v34 row_ror:8 row_mask:0xf bank_mask:0xf
    v_add_f32_dpp v35, v35, v35 row_ror:8 row_mask:0xf bank_mask:0xf
    v_mov_b32 v36, v32
    v_mov_b32 v37, v33
    v_mov_b32 v38, v34
    v_mov_b32 v39, v35
    s_nop 0
    v_permlane16_swap_b32 v32, v36
    v_permlane16_swap_b32 v33, v37
    v_permlane16_swap_b32 v34, v38
    v_permlane16_swap_b32 v35, v39
    v_add_f32 v32, v32, v36
    v_add_f32 v33, v33, v37
    v_add_f32 v34, v34, v38
    v_add_f32 v35, v35, v39
    buffer_store_dwordx4 v[32:35], v27, s[28:31], s57 offen sc1
L_wo_end:
    s_endpgm
L_mlp:
    buffer_load_dwordx4 v67, s[20:23], s60 offen nt lds
    buffer_load_dwordx4 v67, s[20:23], s61 offen offset:1024 nt lds

    s_mul_i32 s57, s4, 14
    s_add_u32 s57, s57, s5
    s_sub_u32 s57, s57, 16

    v_lshlrev_b32 v16, 3, v3
    s_lshl_b32 s45, s3, 7
    v_add_u32 v16, s45, v16
    global_load_dwordx2 v[18:19], v16, s[32:33]
    v_lshlrev_b32 v12, 3, v0
    v_add_u32 v12, s39, v12
    s_lshl_b32 s7, s3, 7
    s_add_u32 s7, s7, 98304
    v_lshlrev_b32 v28, 3, v3
    v_and_b32 v16, 1, v4
    v_lshl_add_u32 v28, v16, 2, v28
    v_lshrrev_b32 v16, 1, v4
    v_lshl_add_u32 v28, v16, 1, v28
    v_add_u32 v28, s7, v28
    v_lshlrev_b32 v29, 3, v4
    v_add_u32 v29, s7, v29
    s_lshl_b32 s7, s3, 6
    s_add_u32 s7, s7, 99328
    v_lshlrev_b32 v26, 2, v0
    v_add_u32 v26, s7, v26
    v_add_u32 v6, 7040, v26
    s_lshl_b32 s7, s3, 3
    s_add_u32 s7, s7, 106304
    v_lshrrev_b32 v27, 5, v0
    v_lshl_add_u32 v27, v27, 2, s7
    v_lshlrev_b32 v9, 4, v3
    s_lshl_b32 s7, s57, 11
    s_lshl_b32 s44, s3, 8
    s_add_u32 s7, s7, s44
    s_add_u32 s60, s7, 1572864
    s_lshl_b32 s61, s3, 8
    v_lshrrev_b32 v16, 2, v3
    v_and_b32 v17, 3, v3
    v_lshlrev_b32 v30, 6, v16
    v_lshl_or_b32 v30, v4, 4, v30
    v_lshl_or_b32 v30, v17, 2, v30
    v_add_u32 v7, 106368, v30
    v_add_u32 v30, 99328, v30
    v_and_b32 v31, 7, v3
    v_lshlrev_b32 v31, 3, v31
    v_add_u32 v31, 106304, v31

    v_lshlrev_b32 v8, 11, v4
    v_lshl_or_b32 v8, v3, 4, v8
    s_lshl_b32 s7, s4, 15
    s_add_u32 s7, s7, 1310720
    s_add_u32 s55, s7, s61
    s_add_u32 s56, s55, 8192
    s_add_u32 s58, s55, 16384
    s_add_u32 s59, s55, 24576

    v_lshrrev_b32 v41, 1, v3
    v_lshlrev_b32 v41, 5, v41
    v_and_b32 v42, 1, v3
    v_add_u32 v41, v41, v42
    s_lshl_b32 s7, s3, 1
    v_add_u32 v41, s7, v41

    s_mul_i32 s44, s43, 0x9e3779b1
    s_add_u32 s44, s44, 0x7f4a7c15
    s_and_b32 s44, s44, 0xfffffff8
    v_lshlrev_b32 v41, 7, v41
    s_mov_b32 s45, 139264
    s_mov_b32 s52, 40000
L_mlp_fl:
    buffer_load_dword v40, v41, s[28:31], s45 offen sc1
    s_waitcnt vmcnt(0)
    v_xor_b32 v40, s44, v40
    v_and_b32 v40, 0xfffffff8, v40
    v_cmp_ne_u32 vcc, 0, v40
    s_cbranch_vccz L_mlp_fl_ok
    s_sub_u32 s52, s52, 1
    s_cbranch_scc0 L_mlp_fl
L_mlp_fl_ok:

    ds_read_b64_tr_b16 v[56:57], v12
    ds_read_b64_tr_b16 v[58:59], v12 offset:512
    ds_read_b64_tr_b16 v[60:61], v12 offset:1024
    ds_read_b64_tr_b16 v[62:63], v12 offset:1536
    v_mov_b32 v64, 0x3f803f80
    v_mov_b32 v65, 0x3f803f80
    v_mov_b32 v66, 0x3f803f80
    v_mov_b32 v67, 0x3f803f80
    v_and_b32 v13, 1, v4
    v_cmp_eq_u32 vcc, 1, v13
    v_cmp_lt_u32 s[44:45], 1, v4
    s_nop 0
    v_cndmask_b32 v13, v18, v19, vcc
    v_lshlrev_b32 v12, 16, v13
    v_and_b32 v13, 0xffff0000, v13
    v_cndmask_b32 v12, v12, v13, s[44:45]
    s_waitcnt lgkmcnt(0)
    v_mfma_f32_16x16x32_bf16 v[68:71], v[64:67], v[56:59], 0
    v_mfma_f32_16x16x32_bf16 v[68:71], v[64:67], v[60:63], v[68:71]
    s_mov_b32 s44, 0x05040100
    s_mov_b32 s45, 0x07060302
    v_perm_b32 v72, v98, v96, s44
    v_perm_b32 v73, v102, v100, s44
    v_perm_b32 v74, v98, v96, s45
    v_perm_b32 v75, v102, v100, s45
    v_perm_b32 v76, v99, v97, s44
    v_perm_b32 v77, v103, v101, s44
    v_perm_b32 v78, v99, v97, s45
    v_perm_b32 v79, v103, v101, s45
    s_mov_b64 exec, 0xffff
    ds_write_b32 v6, v68
    s_mov_b64 exec, -1

    s_mov_b32 s52, 40000
L_mlp_p:
    buffer_load_dwordx4 v[32:35], v8, s[28:31], s55 offen sc1
    buffer_load_dwordx4 v[36:39], v8, s[28:31], s56 offen sc1
    buffer_load_dwordx4 v[40:43], v8, s[28:31], s58 offen sc1
    buffer_load_dwordx4 v[44:47], v8, s[28:31], s59 offen sc1
    s_waitcnt vmcnt(0)
    v_max3_u32 v20, v32, v33, v34
    v_max3_u32 v21, v35, v36, v37
    v_max3_u32 v20, v20, v38, v39
    v_max3_u32 v21, v21, v40, v41
    v_max3_u32 v20, v20, v42, v43
    v_max3_u32 v21, v21, v44, v45
    v_max3_u32 v20, v20, v46, v47
    v_max_u32 v20, v20, v21
    v_cmp_eq_u32 vcc, -1, v20
    s_and_b64 exec, exec, vcc
    s_cbranch_scc0 L_mlp_p_ok
    s_sub_u32 s52, s52, 1
    s_cbranch_scc0 L_mlp_p
L_mlp_p_ok:
    s_mov_b64 exec, -1

    v_pk_add_f32 v[32:33], v[32:33], v[36:37]
    v_pk_add_f32 v[34:35], v[34:35], v[38:39]
    v_pk_add_f32 v[40:41], v[40:41], v[44:45]
    v_pk_add_f32 v[42:43], v[42:43], v[46:47]
    v_pk_add_f32 v[20:21], v[32:33], v[40:41]
    v_pk_add_f32 v[22:23], v[34:35], v[42:43]

    s_nop 0
    v_permlane32_swap_b32 v20, v21
    v_permlane32_swap_b32 v22, v23
    v_add_f32 v20, v20, v21
    v_add_f32 v22, v22, v23
    s_nop 1
    v_permlane16_swap_b32 v20, v22
    v_add_f32 v20, v20, v22
    v_cvt_pk_bf16_f32 v20, v20, v20
    v_and_b32 v20, 0xffff0000, v20
    v_add_f32 v20, v20, v12
    v_cvt_pk_bf16_f32 v24, v20, v20

    ds_write_b16 v28, v24
    v_and_b32 v16, 0xffff0000, v24
    v_mul_f32 v17, v16, v16
    s_waitcnt lgkmcnt(0)
    ds_read2_b64 v[32:35], v29 offset0:0 offset1:4
    ds_read2_b64 v[36:39], v29 offset0:8 offset1:12
    v_permlane32_swap_b32 v16, v17
    v_add_f32 v16, v16, v17

    s_nop 1
    v_add_f32_dpp v16, v16, v16 row_ror:8 row_mask:0xf bank_mask:0xf
    s_nop 1
    v_add_f32_dpp v16, v16, v16 row_ror:4 row_mask:0xf bank_mask:0xf
    s_waitcnt lgkmcnt(0)

    v_mfma_f32_16x16x32_bf16 v[40:43], v[32:35], v[56:59], 0
    v_mfma_f32_16x16x32_bf16 v[40:43], v[36:39], v[60:63], v[40:43]

    s_nop 1
    v_add_f32_dpp v16, v16, v16 row_ror:2 row_mask:0xf bank_mask:0xf
    s_nop 1
    v_add_f32_dpp v16, v16, v16 row_ror:1 row_mask:0xf bank_mask:0xf
    v_mov_b32 v17, v16
    s_nop 1
    v_permlane16_swap_b32 v16, v17
    v_add_f32 v16, v16, v17

    s_mov_b32 exec_lo, 1
    s_mov_b32 exec_hi, 1
    ds_write_b32 v27, v16
    s_mov_b64 exec, 0xffff
    ds_write_b32 v26, v40
    s_mov_b64 exec, -1
    s_waitcnt lgkmcnt(0)

    s_barrier

    ds_read_b64 v[32:33], v31
    ds_read_b32 v92, v30
    ds_read_b32 v93, v30 offset:256
    ds_read_b32 v88, v7
    ds_read_b32 v89, v7 offset:256
    s_mov_b32 s46, 0x3b000000
    v_mov_b32 v34, 0x3727c5ac
    s_waitcnt lgkmcnt(0)

    v_add_f32 v92, v92, v93
    v_add_f32 v88, v88, v89
    v_add_f32_dpp v32, v32, v32 row_ror:1 row_mask:0xf bank_mask:0xf
    v_add_f32_dpp v33, v33, v33 row_ror:1 row_mask:0xf bank_mask:0xf
    v_add_f32_dpp v92, v92, v92 row_ror:4 row_mask:0xf bank_mask:0xf
    v_add_f32_dpp v88, v88, v88 row_ror:4 row_mask:0xf bank_mask:0xf
    v_add_f32_dpp v32, v32, v32 row_ror:2 row_mask:0xf bank_mask:0xf
    v_add_f32_dpp v33, v33, v33 row_ror:2 row_mask:0xf bank_mask:0xf
    v_add_f32_dpp v92, v92, v92 row_ror:8 row_mask:0xf bank_mask:0xf
    v_add_f32_dpp v88, v88, v88 row_ror:8 row_mask:0xf bank_mask:0xf
    v_add_f32_dpp v32, v32, v32 row_ror:4 row_mask:0xf bank_mask:0xf
    v_add_f32_dpp v33, v33, v33 row_ror:4 row_mask:0xf bank_mask:0xf
    v_mul_f32 v32, 0x3b000000, v32
    v_fma_f32 v33, v33, s46, v34
    v_fma_f32 v92, -v32, v88, v92
    v_fma_f32 v33, -v32, v32, v33
    v_max_f32 v33, v33, v34
    v_rsq_f32 v33, v33
    s_nop 0
    v_mul_f32 v92, v92, v33
    v_cvt_pk_bf16_f32 v92, v92, v92
    v_and_b32 v92, 0xffff0000, v92
    v_mul_f32 v36, 0xbfb8aa3b, v92
    v_exp_f32 v36, v36
    s_nop 0
    v_add_f32 v36, 1.0, v36
    v_rcp_f32 v36, v36
    s_nop 0
    v_mul_f32 v92, v92, v36
    v_cvt_pk_bf16_f32 v92, v92, v92
    s_mov_b32 s44, 0x05040100
    s_nop 0
    v_mov_b32_dpp v36, v92 quad_perm:[0,0,0,0] row_mask:0xf bank_mask:0xf
    v_mov_b32_dpp v37, v92 quad_perm:[1,1,1,1] row_mask:0xf bank_mask:0xf
    v_mov_b32_dpp v38, v92 quad_perm:[2,2,2,2] row_mask:0xf bank_mask:0xf
    v_mov_b32_dpp v39, v92 quad_perm:[3,3,3,3] row_mask:0xf bank_mask:0xf
    v_perm_b32 v34, v37, v36, s44
    v_perm_b32 v35, v39, v38, s44
    s_nop 1

    v_mfma_f32_16x16x16_bf16 v[36:39], v[34:35], v[72:73], 0
    v_mfma_f32_16x16x16_bf16 v[40:43], v[34:35], v[74:75], 0
    v_mfma_f32_16x16x16_bf16 v[44:47], v[34:35], v[76:77], 0
    v_mfma_f32_16x16x16_bf16 v[48:51], v[34:35], v[78:79], 0
    s_mov_b64 exec, 0xffff
    s_nop 4
    v_mov_b32 v52, v36
    v_mov_b32 v53, v40
    v_mov_b32 v54, v44
    v_mov_b32 v55, v48
    buffer_store_dwordx4 v[52:55], v9, s[28:31], s60 offen sc1
    s_mov_b64 exec, -1

    s_endpgm
L_fin:

    s_lshl_b32 s57, s4, 1
    s_add_u32 s57, s57, s5
    s_sub_u32 s57, s57, 30
    v_and_b32 v16, 7, v3
    v_lshlrev_b32 v16, 3, v16
    s_lshl_b32 s45, s57, 6
    v_add_u32 v16, s45, v16
    global_load_dwordx2 v[18:19], v16, s[32:33]
    v_and_b32 v5, 7, v0
    v_lshrrev_b32 v6, 3, v0
    v_lshlrev_b32 v10, 11, v6
    v_lshl_or_b32 v10, v5, 4, v10
    s_lshl_b32 s7, s3, 14
    s_lshl_b32 s44, s57, 7
    s_add_u32 s7, s7, s44
    s_add_u32 s60, s7, 1572864
    s_add_u32 s61, s60, 131072
    s_cmp_lt_u32 s3, 6
    s_cselect_b32 s61, s61, s60
    s_cselect_b32 s41, 1.0, 0
    v_and_b32 v6, 1, v4
    v_lshlrev_b32 v6, 1, v6
    v_lshrrev_b32 v7, 1, v4
    v_add_u32 v6, v6, v7
    v_lshl_add_u32 v6, v5, 2, v6
    s_lshl_b32 s7, s3, 7
    s_add_u32 s7, s7, 104256
    v_lshl_add_u32 v7, v6, 2, s7
    v_lshlrev_b32 v11, 1, v6
    s_lshl_b32 s7, s57, 6
    v_add_u32 v11, s7, v11
    v_bfe_u32 v9, v0, 3, 1
    v_lshlrev_b32 v9, 9, v9
    v_lshl_add_u32 v6, v6, 2, v9
    v_add_u32 v6, 104256, v6
    v_and_b32 v41, 7, v0
    v_bfe_u32 v42, v0, 3, 1
    v_lshl_add_u32 v41, v42, 6, v41
    s_lshl_b32 s7, s3, 3
    v_add_u32 v41, s7, v41
    v_min_u32 v41, 111, v41
    v_mul_u32_u24 v42, 4682, v41
    v_lshrrev_b32 v42, 16, v42
    v_mul_u32_u24 v43, 18, v42
    v_add_u32 v41, v41, v43
    v_add_u32 v41, 16, v41
    v_bfe_u32 v42, v0, 1, 3
    v_lshlrev_b32 v42, 5, v42
    v_and_b32 v43, 1, v0
    v_add_u32 v42, v42, v43
    s_and_b32 s7, s57, 14
    v_add_u32 v42, s7, v42
    v_cmp_lt_u32 vcc, 15, v0
    s_nop 1
    v_cndmask_b32 v41, v41, v42, vcc

    s_mul_i32 s44, s43, 0x9e3779b1
    s_add_u32 s44, s44, 0x7f4a7c15
    s_and_b32 s44, s44, 0xfffffff8
    v_lshlrev_b32 v41, 7, v41
    s_mov_b32 s45, 139264
    s_mov_b32 s52, 40000
L_fin_fl:
    buffer_load_dword v40, v41, s[28:31], s45 offen sc1
    s_waitcnt vmcnt(0)
    v_xor_b32 v40, s44, v40
    v_and_b32 v40, 0xfffffff8, v40
    v_cmp_ne_u32 vcc, 0, v40
    s_cbranch_vccz L_fin_fl_ok
    s_sub_u32 s52, s52, 1
    s_cbranch_scc0 L_fin_fl
L_fin_fl_ok:

    v_and_b32 v13, 1, v4
    v_cmp_eq_u32 vcc, 1, v13
    v_cmp_lt_u32 s[44:45], 1, v4
    s_nop 0
    v_cndmask_b32 v13, v18, v19, vcc
    v_lshlrev_b32 v12, 16, v13
    v_and_b32 v13, 0xffff0000, v13
    v_cndmask_b32 v12, v12, v13, s[44:45]
    s_cmp_lg_u32 s3, 0
    s_cbranch_scc1 L_fin_h4
    v_and_b32 v3, 7, v3
    s_lshl_b32 s40, s57, 7

    v_lshlrev_b32 v8, 11, v4
    v_lshl_or_b32 v8, v3, 4, v8
    s_lshl_b32 s7, s4, 15
    s_add_u32 s7, s7, 1310720
    s_add_u32 s55, s7, s40
    s_add_u32 s56, s55, 8192
    s_add_u32 s58, s55, 16384
    s_add_u32 s59, s55, 24576

    s_mov_b32 s52, 40000
L_fin_p:
    buffer_load_dwordx4 v[32:35], v8, s[28:31], s55 offen sc1
    buffer_load_dwordx4 v[36:39], v8, s[28:31], s56 offen sc1
    buffer_load_dwordx4 v[40:43], v8, s[28:31], s58 offen sc1
    buffer_load_dwordx4 v[44:47], v8, s[28:31], s59 offen sc1
    s_waitcnt vmcnt(0)
    v_max3_u32 v20, v32, v33, v34
    v_max3_u32 v21, v35, v36, v37
    v_max3_u32 v20, v20, v38, v39
    v_max3_u32 v21, v21, v40, v41
    v_max3_u32 v20, v20, v42, v43
    v_max3_u32 v21, v21, v44, v45
    v_max3_u32 v20, v20, v46, v47
    v_max_u32 v20, v20, v21
    v_cmp_eq_u32 vcc, -1, v20
    s_and_b64 exec, exec, vcc
    s_cbranch_scc0 L_fin_p_ok
    s_sub_u32 s52, s52, 1
    s_cbranch_scc0 L_fin_p
L_fin_p_ok:
    s_mov_b64 exec, -1

    v_pk_add_f32 v[32:33], v[32:33], v[36:37]
    v_pk_add_f32 v[34:35], v[34:35], v[38:39]
    v_pk_add_f32 v[40:41], v[40:41], v[44:45]
    v_pk_add_f32 v[42:43], v[42:43], v[46:47]
    v_pk_add_f32 v[20:21], v[32:33], v[40:41]
    v_pk_add_f32 v[22:23], v[34:35], v[42:43]

    s_nop 0
    v_permlane32_swap_b32 v20, v21
    v_permlane32_swap_b32 v22, v23
    v_add_f32 v20, v20, v21
    v_add_f32 v22, v22, v23
    s_nop 1
    v_permlane16_swap_b32 v20, v22
    v_add_f32 v20, v20, v22
    v_cvt_pk_bf16_f32 v20, v20, v20
    v_and_b32 v20, 0xffff0000, v20
    v_add_f32 v20, v20, v12
    v_cvt_pk_bf16_f32 v24, v20, v20

    v_and_b32 v20, 0xffff0000, v24
    s_cmp_lg_u32 s57, 0
    s_cbranch_scc1 L_fin_h4
    s_add_u32 s7, s43, 1
    v_mov_b32 v26, s7
    v_mov_b32 v27, 0
    s_mov_b64 exec, 1
    buffer_store_dword v26, v27, s[28:31], 0 offen sc1
    s_mov_b64 exec, -1
L_fin_h4:

    s_mov_b32 s52, 40000
L_fin_p4:
    buffer_load_dwordx4 v[32:35], v10, s[28:31], s60 offen sc1
    buffer_load_dwordx4 v[36:39], v10, s[28:31], s61 offen sc1
    s_waitcnt vmcnt(0)
    v_max3_u32 v40, v32, v33, v34
    v_max3_u32 v41, v35, v36, v37
    v_max3_u32 v40, v40, v38, v39
    v_max_u32 v40, v40, v41
    v_cmp_eq_u32 vcc, -1, v40
    s_and_b64 exec, exec, vcc
    s_cbranch_scc0 L_fin_p4_ok
    s_sub_u32 s52, s52, 1
    s_cbranch_scc0 L_fin_p4
L_fin_p4_ok:
    s_mov_b64 exec, -1
    v_fma_f32 v32, v36, s41, v32
    v_fma_f32 v33, v37, s41, v33
    v_fma_f32 v34, v38, s41, v34
    v_fma_f32 v35, v39, s41, v35

    s_nop 0
    v_permlane32_swap_b32 v32, v33
    v_permlane32_swap_b32 v34, v35
    v_add_f32 v32, v32, v33
    v_add_f32 v34, v34, v35
    s_nop 1
    v_permlane16_swap_b32 v32, v34
    v_add_f32 v32, v32, v34
    s_nop 1
    v_add_f32_dpp v32, v32, v32 row_ror:8 row_mask:0xf bank_mask:0xf
    s_mov_b32 exec_lo, 0x00ff00ff
    s_mov_b32 exec_hi, 0x00ff00ff
    ds_write_b32 v7, v32
    s_mov_b64 exec, -1
    s_waitcnt lgkmcnt(0)
    s_barrier
    s_cmp_lg_u32 s3, 0
    s_cbranch_scc1 L_fin_end
    ds_read2_b32 v[32:33], v6 offset0:0 offset1:32
    ds_read2_b32 v[34:35], v6 offset0:64 offset1:96
    s_waitcnt lgkmcnt(0)
    v_add_f32 v32, v32, v33
    v_add_f32 v34, v34, v35
    v_add_f32 v32, v32, v34
    s_nop 1
    v_add_f32_dpp v32, v32, v32 row_ror:8 row_mask:0xf bank_mask:0xf

    v_cvt_pk_bf16_f32 v32, v32, v32
    v_and_b32 v32, 0xffff0000, v32
    v_add_f32 v32, v32, v20
    v_cvt_pk_bf16_f32 v36, v32, v32
    s_mov_b32 exec_lo, 0x00ff00ff
    s_mov_b32 exec_hi, 0x00ff00ff
    global_store_short v11, v36, s[34:35]

L_fin_end:
    s_mov_b64 exec, -1

    s_endpgm
L_exit:
    s_endpgm
.section .rodata,"a"
.p2align 6
.amdhsa_kernel sequential_preLN__sliding_block_cached__dense_activation_silu__decode_kernel
  .amdhsa_next_free_vgpr 128
  .amdhsa_next_free_sgpr 100
  .amdhsa_accum_offset 128
  .amdhsa_group_segment_fixed_size 0
  .amdhsa_kernarg_size 88
  .amdhsa_user_sgpr_count 2
  .amdhsa_user_sgpr_kernarg_segment_ptr 1
  .amdhsa_system_sgpr_workgroup_id_x 1
  .amdhsa_float_denorm_mode_32 3
.end_amdhsa_kernel
```
